```python
import torch

def _softmax(x, axis=-1):
    return torch.softmax(x, dim=axis)
def _gelu(x):
    return torch.nn.functional.gelu(x, approximate="tanh")
def _silu(x):
    return torch.nn.functional.silu(x)
def _sigmoid(x):
    return torch.sigmoid(x)
def _layernorm(x, axis=-1, eps=1e-5):
    m = x.mean(dim=axis, keepdim=True)
    v = x.var(dim=axis, keepdim=True, unbiased=False)
    return (x - m) / torch.sqrt(v + eps)
def _scatter_add(tgt, idx, src, axis=0):
    return tgt.clone().index_add_(axis, idx, src)
def _segment_sum(src, seg, n):
    out = torch.zeros((n,) + src.shape[1:], dtype=src.dtype)
    return out.index_add_(0, seg, src)
def _pad(x, pw):
    flat = tuple(v for pair in reversed(pw) for v in pair)
    return torch.nn.functional.pad(x, flat)

kernel_name = 'gather_scatter__kernel_systems_refs_featgraph__graph'

def setup_inputs():

    _w = (lambda a: (lambda t: t.to(torch.bfloat16) if t.is_floating_point() else t)(torch.as_tensor(a)))
    N, deg, D = 10000, 32, 128
    E = N * deg
    scale = D ** -0.5
    src = (lambda lo, hi, *s: torch.randint(lo, hi, s))(0, N, E).to(torch.int64)
    dst = (lambda lo, hi, *s: torch.randint(lo, hi, s))(0, N, E).to(torch.int64)
    return {
        "x": _w((lambda *s: torch.randn(*s, dtype=torch.bfloat16) * 0.8)(N, D)),
        "src": _w(src),
        "dst": _w(dst),
        "w_q": _w((lambda *s: torch.randn(*s, dtype=torch.bfloat16) * 0.8)(D, D) * scale),
        "w_v": _w((lambda *s: torch.randn(*s, dtype=torch.bfloat16) * 0.05)(D, D) * scale),
    }

def reference(x, src, dst, w_q, w_v):
    N, D = x.shape
    xs = x[src]
    xd = x[dst]
    q = xd @ w_q
    logits = torch.einsum('ed,ed->e', xs, q) * (float(D) ** -0.5)
    alpha = _sigmoid(logits)
    msg = alpha[:, None] * (xs @ w_v)
    return _segment_sum(msg, dst, N)
```

```asm
; @launch grid=(251,1,1) block=(1024,1,1) lds=161920
.amdgcn_target "amdgcn-amd-amdhsa--gfx950"
.text
.globl gather_scatter__kernel_systems_refs_featgraph__graph_kernel
.p2align 12
.fill 832, 4, 0xBF800000
.p2align 8
.type gather_scatter__kernel_systems_refs_featgraph__graph_kernel,@function
gather_scatter__kernel_systems_refs_featgraph__graph_kernel:
    s_cmp_ge_u32 s2, 251
    s_cbranch_scc1 L_end
    s_load_dwordx16 s[8:23], s[0:1], 0
    s_cmp_eq_u32 s2, 250
    s_cbranch_scc1 L_chk
    v_lshrrev_b32 v28, 6, v0
    v_and_b32 v1, 63, v0
    v_readfirstlane_b32 s3, v28
    v_and_b32 v2, 15, v0
    v_bfe_u32 v3, v0, 4, 2
    v_lshlrev_b32 v122, 4, v0
    s_lshr_b32 s54, s2, 4
    s_and_b32 s55, s2, 7
    s_lshl_b32 s54, s54, 3
    s_add_u32 s54, s54, s55
    s_bitcmp1_b32 s2, 3
    s_mov_b32 s36, s54
    s_and_b32 s55, s2, 7
    s_lshl_b32 s55, s55, 4
    s_lshr_b32 s56, s2, 4
    s_add_u32 s55, s55, s56
    s_bitcmp1_b32 s2, 3
    s_cselect_b32 s101, 0xffff, s55
    s_cmp_ge_u32 s36, 125
    s_cselect_b32 s101, 0xffff, s101
    s_mul_i32 s54, s54, 10240
    v_add_u32 v123, s54, v122
    v_mov_b32 v31, 0
    v_lshlrev_b32 v28, 2, v3
    v_xor_b32 v4, v28, v2
    v_lshlrev_b32 v4, 4, v4
    v_and_b32 v7, 3, v2
    s_mul_i32 s41, s3, 8448
    s_add_u32 s41, s41, 26752
    s_mov_b32 s53, 0
    s_mov_b32 s47, 0
    s_mov_b32 s60, 0x88888888
    s_mov_b32 s61, 0x88888888
    s_waitcnt lgkmcnt(0)
    s_cmp_ge_u32 s3, 10
    s_cbranch_scc1 L_noedge
    s_cmp_ge_u32 s101, 128
    s_cbranch_scc1 L_notp0
    global_load_dwordx4 v[32:35], v123, s[12:13]
    global_load_dwordx4 v[36:39], v123, s[10:11]
    s_branch L_noedge
L_notp0:
    s_cmp_ge_u32 s3, 2
    s_cbranch_scc1 L_noedge
    s_cmp_ge_u32 s36, 125
    s_cbranch_scc1 L_noedge
    s_mul_i32 s54, s36, 10240
    s_add_u32 s54, s54, 5120
    v_lshlrev_b32 v28, 7, v1
    v_add_u32 v28, s54, v28
    s_cmp_eq_u32 s3, 0
    s_cselect_b32 s54, s12, s10
    s_cselect_b32 s55, s13, s11
    s_mov_b32 exec_lo, -1
    s_mov_b32 exec_hi, 0xff
    global_load_dword v127, v28, s[54:55]
    s_mov_b64 exec, -1
L_noedge:
    global_load_dword v126, v31, s[22:23]
    s_add_u32 s42, s22, 262144000
    s_addc_u32 s43, s23, 0
    s_cmp_lg_u32 s3, 11
    s_cbranch_scc1 L_nowpf
    s_lshr_b32 s54, s2, 3
    s_lshl_b32 s54, s54, 3
    v_add_u32 v28, s54, v1
    v_and_b32 v28, 255, v28
    v_lshlrev_b32 v28, 7, v28
    s_mov_b64 exec, 0xffff
    global_load_dword v127, v28, s[14:15]
    global_load_dword v127, v28, s[16:17]
    s_mov_b64 exec, -1
L_nowpf:
    s_mov_b32 s4, s8
    s_mov_b32 s5, s9
    s_mov_b32 s6, 2560000
    s_mov_b32 s7, 0x20000
    s_cmp_lg_u32 s3, 11
    s_cbranch_scc1 L_pfe_done
    s_cmp_lt_u32 s101, 128
    s_cbranch_scc1 L_pfe_done
    s_lshr_b32 s54, s2, 4
    s_mul_i32 s54, s54, 1280
    s_and_b32 s55, s2, 7
    s_mul_i32 s55, s55, 80
    s_movk_i32 s56, 560
    v_add_u32 v28, 0, v1
    v_cmp_le_u32 vcc, s56, v28
    v_mov_b32 v29, 80
    v_cndmask_b32 v30, 0, v29, vcc
    v_mul_u32_u24 v31, 7, v30
    v_sub_u32 v31, v28, v31
    v_cmp_le_u32 vcc, s55, v31
    s_nop 1
    v_cndmask_b32 v29, 0, v29, vcc
    v_add3_u32 v28, v28, v29, v30
    v_add_lshl_u32 v28, v28, s54, 7
    buffer_load_dword v127, v28, s[4:7], 0 offen
    v_add_u32 v28, 64, v1
    v_cmp_le_u32 vcc, s56, v28
    v_mov_b32 v29, 80
    v_cndmask_b32 v30, 0, v29, vcc
    v_mul_u32_u24 v31, 7, v30
    v_sub_u32 v31, v28, v31
    v_cmp_le_u32 vcc, s55, v31
    s_nop 1
    v_cndmask_b32 v29, 0, v29, vcc
    v_add3_u32 v28, v28, v29, v30
    v_add_lshl_u32 v28, v28, s54, 7
    buffer_load_dword v127, v28, s[4:7], 0 offen
    v_add_u32 v28, 128, v1
    v_cmp_le_u32 vcc, s56, v28
    v_mov_b32 v29, 80
    v_cndmask_b32 v30, 0, v29, vcc
    v_mul_u32_u24 v31, 7, v30
    v_sub_u32 v31, v28, v31
    v_cmp_le_u32 vcc, s55, v31
    s_nop 1
    v_cndmask_b32 v29, 0, v29, vcc
    v_add3_u32 v28, v28, v29, v30
    v_add_lshl_u32 v28, v28, s54, 7
    buffer_load_dword v127, v28, s[4:7], 0 offen
    v_add_u32 v28, 192, v1
    v_cmp_le_u32 vcc, s56, v28
    v_mov_b32 v29, 80
    v_cndmask_b32 v30, 0, v29, vcc
    v_mul_u32_u24 v31, 7, v30
    v_sub_u32 v31, v28, v31
    v_cmp_le_u32 vcc, s55, v31
    s_nop 1
    v_cndmask_b32 v29, 0, v29, vcc
    v_add3_u32 v28, v28, v29, v30
    v_add_lshl_u32 v28, v28, s54, 7
    buffer_load_dword v127, v28, s[4:7], 0 offen
L_pfe_done:
    v_mov_b32 v28, 0x3fffff
    v_mov_b32 v29, v28
    v_mov_b32 v30, v28
    v_mov_b32 v31, v28
    s_cmp_ge_u32 s3, 12
    s_cbranch_scc1 L_init_cnt
    ds_write_b128 v122, v[28:31] offset:0
    s_branch L_init_stage
L_init_cnt:
    v_mov_b32 v64, 0
    v_mov_b32 v65, 0
    v_mov_b32 v66, 0
    v_mov_b32 v67, 0
    v_cmp_gt_u32 vcc, 844, v0
    s_and_saveexec_b64 s[54:55], vcc
    s_cbranch_execz L_init_cnt_done
    ds_write_b128 v122, v[64:67] offset:13248
L_init_cnt_done:
    s_mov_b64 exec, s[54:55]
L_init_stage:
    s_cmp_ge_u32 s101, 128
    s_cbranch_scc1 L_init_done
    v_mov_b32 v68, 0xfffff
    v_mov_b32 v69, 0xfffff
    v_mov_b32 v70, 0xfffff
    v_mov_b32 v71, 0xfffff
    ds_write_b128 v122, v[68:71] offset:26752
    ds_write_b128 v122, v[68:71] offset:43136
    v_cmp_gt_u32 vcc, 77, v0
    s_and_saveexec_b64 s[54:55], vcc
    s_cbranch_execz L_init_st2
    ds_write_b128 v122, v[68:71] offset:59520
L_init_st2:
    s_mov_b64 exec, s[54:55]
L_init_done:
    s_waitcnt lgkmcnt(0)
    s_barrier
    s_cmp_ge_u32 s3, 12
    s_cbranch_scc1 L_qgemm
    s_cmp_ge_u32 s3, 10
    s_cbranch_scc1 L_aux
    s_cmp_ge_u32 s101, 128
    s_cbranch_scc1 L_notprod
    s_setprio 3
    v_lshrrev_b32 v28, 2, v0
    v_and_b32 v29, 1, v28
    v_bfe_u32 v30, v28, 1, 3
    v_and_b32 v28, -16, v28
    v_lshl_or_b32 v28, v29, 3, v28
    v_or_b32 v28, v28, v30
    v_and_b32 v29, 3, v0
    v_mul_u32_u24 v22, 24, v29
    s_movk_i32 s55, 136
    v_mad_u32_u24 v22, v28, s55, v22
    v_add_u32 v22, 26752, v22
    v_lshlrev_b32 v23, 2, v28
    s_lshl_b32 s54, s101, 14
    v_lshl_add_u32 v24, v0, 4, s54
    s_movk_i32 s54, -40
    s_movk_i32 s55, 136
    v_mov_b32 v31, 4
    s_waitcnt vmcnt(1)
    v_mul_u32_u24 v40, 52429, v32
    v_lshrrev_b32 v40, 21, v40
    v_lshlrev_b32 v30, 2, v40
    ds_add_rtn_u32 v48, v30, v31 offset:25536
    v_mad_i32_i24 v28, v40, s54, v32
    v_lshl_or_b32 v44, v36, 6, v28
    v_mul_u32_u24 v41, 52429, v33
    v_lshrrev_b32 v41, 21, v41
    v_lshlrev_b32 v30, 2, v41
    ds_add_rtn_u32 v49, v30, v31 offset:25536
    v_mad_i32_i24 v28, v41, s54, v33
    v_lshrrev_b32 v29, 5, v28
    v_lshl_add_u32 v28, v29, 3, v28
    v_lshl_or_b32 v45, v37, 6, v28
    v_mul_u32_u24 v42, 52429, v34
    v_lshrrev_b32 v42, 21, v42
    v_lshlrev_b32 v30, 2, v42
    ds_add_rtn_u32 v50, v30, v31 offset:25536
    v_mad_i32_i24 v28, v42, s54, v34
    v_lshl_or_b32 v46, v38, 6, v28
    v_mul_u32_u24 v43, 52429, v35
    v_lshrrev_b32 v43, 21, v43
    v_lshlrev_b32 v30, 2, v43
    ds_add_rtn_u32 v51, v30, v31 offset:25536
    v_mad_i32_i24 v28, v43, s54, v35
    v_lshrrev_b32 v29, 5, v28
    v_lshl_add_u32 v28, v29, 3, v28
    v_lshl_or_b32 v47, v39, 6, v28
    s_waitcnt lgkmcnt(3)
    v_min_u32 v48, 124, v48
    v_mad_u32_u24 v40, v40, s55, v48
    ds_write_b32 v40, v44 offset:26752
    s_waitcnt lgkmcnt(3)
    v_min_u32 v49, 124, v49
    v_mad_u32_u24 v41, v41, s55, v49
    ds_write_b32 v41, v45 offset:26752
    s_waitcnt lgkmcnt(3)
    v_min_u32 v50, 124, v50
    v_mad_u32_u24 v42, v42, s55, v50
    ds_write_b32 v42, v46 offset:26752
    s_waitcnt lgkmcnt(3)
    v_min_u32 v51, 124, v51
    v_mad_u32_u24 v43, v43, s55, v51
    ds_write_b32 v43, v47 offset:26752
    v_mov_b32 v28, 0
    v_mov_b32 v29, 1
    s_mov_b64 exec, 1
    s_waitcnt lgkmcnt(0)
    ds_add_u32 v28, v29 offset:26692
    s_mov_b64 exec, -1
    s_waitcnt vmcnt(0)
    v_readfirstlane_b32 s40, v126
    s_xor_b32 s37, s40, 0x5bd1e995
    v_and_b32 v28, 3, v0
    v_mul_u32_u24 v28, 85, v28
    s_add_u32 s54, s40, 1
    v_add_u32 v28, s54, v28
    v_lshlrev_b32 v28, 24, v28
    s_xor_b32 s54, s40, 0x05a5a5a5
    s_lshl_b32 s54, s54, 4
    v_mov_b32 v29, s54
    v_cndmask_b32 v20, v28, v29, s[60:61]
    v_mov_b32 v28, 0xff000000
    v_mov_b32 v29, -16
    v_cndmask_b32 v21, v28, v29, s[60:61]
    s_cmp_lg_u32 s3, 0
    s_cbranch_scc1 L_nofla
    s_and_b32 s54, s101, 15
    s_cmp_lg_u32 s54, 14
    s_cbranch_scc1 L_nofla
    s_lshr_b32 s54, s101, 4
    s_lshl_b32 s54, s54, 8
    s_add_u32 s54, s54, 4194304
    v_mov_b32 v28, s54
    v_mov_b32 v29, s37
    s_mov_b64 exec, 1
    global_store_dword v28, v29, s[42:43] sc1
    s_mov_b64 exec, -1
L_nofla:
L_wo_shared:
    v_mov_b32 v28, 0
L_spina:
    ds_read_b32 v29, v28 offset:26692
    s_waitcnt lgkmcnt(0)
    v_readfirstlane_b32 s54, v29
    s_cmp_lt_u32 s54, 10
    s_cbranch_scc1 L_spina
    s_setprio 3
    ds_read2_b64 v[32:35], v22 offset0:0 offset1:1
    ds_read_b64 v[36:37], v22 offset:16
    ds_read_b32 v25, v23 offset:25536
    v_cmp_gt_u32 vcc, 1000, v23
    s_mov_b64 exec, vcc
    s_waitcnt lgkmcnt(1)
    v_lshl_or_b32 v40, v33, 20, v32
    v_lshrrev_b32 v28, 12, v33
    v_lshl_or_b32 v41, v34, 8, v28
    v_lshl_or_b32 v41, v35, 28, v41
    v_lshrrev_b32 v28, 4, v35
    v_lshl_or_b32 v42, v36, 16, v28
    v_cndmask_b32 v37, v37, 0, s[60:61]
    v_lshrrev_b32 v28, 16, v36
    v_lshl_or_b32 v43, v37, 4, v28
    v_or_b32 v43, v20, v43
    global_store_dwordx4 v24, v[40:43], s[42:43] sc1
    s_waitcnt lgkmcnt(0)
    v_cmp_le_u32 vcc, 92, v25
    s_and_b64 exec, exec, vcc
    s_cbranch_execz L_wo2_skip16
    ds_read2_b32 v[32:33], v22 offset0:23 offset1:24
    ds_read2_b32 v[34:35], v22 offset0:25 offset1:26
    ds_read2_b32 v[36:37], v22 offset0:27 offset1:28
    v_mov_b32 v29, 0xfffff
    s_mov_b32 s54, 0xcccccccc
    s_mov_b32 s55, 0xcccccccc
    s_mov_b32 s58, 0xeeeeeeee
    s_mov_b32 s59, 0xeeeeeeee
    v_add_u32 v30, 2097152, v24
    s_waitcnt lgkmcnt(0)
    v_cndmask_b32 v32, v32, v29, s[54:55]
    v_cndmask_b32 v33, v33, v29, s[54:55]
    v_cndmask_b32 v34, v34, v29, s[54:55]
    v_cndmask_b32 v35, v35, v29, s[58:59]
    v_cndmask_b32 v36, v36, v29, s[58:59]
    v_cndmask_b32 v37, v37, v29, s[58:59]
    v_lshl_or_b32 v40, v33, 20, v32
    v_lshrrev_b32 v28, 12, v33
    v_lshl_or_b32 v41, v34, 8, v28
    v_lshl_or_b32 v41, v35, 28, v41
    v_lshrrev_b32 v28, 4, v35
    v_lshl_or_b32 v42, v36, 16, v28
    v_cndmask_b32 v37, v37, 0, s[60:61]
    v_lshrrev_b32 v28, 16, v36
    v_lshl_or_b32 v43, v37, 4, v28
    v_or_b32 v43, v20, v43
    global_store_dwordx4 v30, v[40:43], s[42:43] sc1
L_wo2_skip16:
    s_mov_b64 exec, -1
    v_mov_b32 v28, 0
    v_mov_b32 v29, 0x100
    s_mov_b64 exec, 1
    ds_add_u32 v28, v29 offset:26700
    s_mov_b64 exec, -1
    s_setprio 0
    s_cmp_ge_u32 s3, 12
    s_cbranch_scc1 L_q_wo_done
    s_cmp_ge_u32 s3, 10
    s_cbranch_scc1 L_aux_wo_done
    s_branch L_tagged
L_notprod:
    s_waitcnt vmcnt(0)
    s_cmp_lt_u32 s3, 8
    s_cbranch_scc1 L_noxp
    s_cmp_ge_u32 s36, 125
    s_cbranch_scc1 L_noxp
    s_sub_u32 s54, s2, 8
    s_mul_i32 s54, s54, 10240
    s_sub_u32 s55, s3, 8
    s_lshl_b32 s55, s55, 13
    s_add_u32 s54, s54, s55
    v_lshlrev_b32 v28, 7, v1
    v_add_u32 v28, s54, v28
    s_cmp_eq_u32 s3, 8
    s_cselect_b64 exec, -1, 0xffff
    buffer_load_dword v127, v28, s[4:7], 0 offen
    s_mov_b64 exec, -1
L_noxp:
    v_readfirstlane_b32 s40, v126
    s_xor_b32 s37, s40, 0x5bd1e995
    v_and_b32 v28, 3, v0
    v_mul_u32_u24 v28, 85, v28
    s_add_u32 s54, s40, 1
    v_add_u32 v28, s54, v28
    v_lshlrev_b32 v28, 24, v28
    s_xor_b32 s54, s40, 0x05a5a5a5
    s_lshl_b32 s54, s54, 4
    v_mov_b32 v29, s54
    v_cndmask_b32 v20, v28, v29, s[60:61]
    v_mov_b32 v28, 0xff000000
    v_mov_b32 v29, -16
    v_cndmask_b32 v21, v28, v29, s[60:61]
    s_cmp_ge_u32 s3, 8
    s_cbranch_scc1 L_tagged
    v_mov_b32 v28, 0
    v_mov_b32 v29, 1
    s_mov_b64 exec, 1
    ds_add_u32 v28, v29 offset:26712
    s_mov_b64 exec, -1
L_tagged:
    v_lshrrev_b32 v28, 2, v2
    s_movk_i32 s54, 1056
    v_mul_u32_u24 v29, s54, v28
    v_lshl_add_u32 v29, v7, 8, v29
    v_lshl_add_u32 v29, v3, 4, v29
    v_add_u32 v29, s41, v29
    v_xor_b32 v30, 0, v7
    v_lshl_add_u32 v8, v30, 6, v29
    v_xor_b32 v30, 1, v7
    v_lshl_add_u32 v9, v30, 6, v29
    v_xor_b32 v30, 2, v7
    v_lshl_add_u32 v10, v30, 6, v29
    v_xor_b32 v30, 3, v7
    v_lshl_add_u32 v11, v30, 6, v29
    v_and_b32 v29, 1, v3
    v_lshrrev_b32 v30, 1, v3
    v_lshl_add_u32 v29, v29, 2, v30
    v_mul_u32_u24 v29, s54, v29
    v_and_b32 v30, 1, v28
    v_lshl_add_u32 v29, v30, 5, v29
    v_lshl_add_u32 v29, v7, 3, v29
    v_lshrrev_b32 v31, 1, v28
    v_lshl_add_u32 v29, v31, 8, v29
    v_add_u32 v29, s41, v29
    v_xor_b32 v30, 0, v31
    v_lshl_add_u32 v12, v30, 6, v29
    v_xor_b32 v30, 1, v31
    v_lshl_add_u32 v13, v30, 6, v29
    v_xor_b32 v30, 2, v31
    v_lshl_add_u32 v14, v30, 6, v29
    v_xor_b32 v30, 3, v31
    v_lshl_add_u32 v15, v30, 6, v29
    s_mul_i32 s54, s3, 768
    v_and_b32 v29, 7, v2
    v_lshl_add_u32 v29, v29, 2, v3
    v_lshlrev_b32 v29, 2, v29
    v_add_u32 v5, s54, v29
    v_and_b32 v29, 1, v28
    v_lshlrev_b32 v30, 6, v29
    v_lshl_add_u32 v30, v3, 4, v30
    v_add_u32 v6, s54, v30
    v_lshrrev_b32 v30, 1, v3
    v_lshlrev_b32 v30, 7, v30
    v_lshl_add_u32 v30, v2, 3, v30
    s_mul_i32 s54, s3, 272
    v_add_u32 v16, s54, v30
    s_lshr_b32 s54, s3, 2
    s_lshl_b32 s54, s54, 3
    s_lshl_b32 s54, 1, s54
    v_mov_b32 v17, s54
    s_mov_b32 s44, 0xf0f0f0f0
    s_mov_b32 s45, 0xf0f0f0f0
    v_mov_b32 v64, 0
    v_mov_b32 v65, 0
    v_mov_b32 v66, 0
    v_mov_b32 v67, 0
    v_mov_b32 v68, 0
    v_mov_b32 v69, 0
    v_mov_b32 v70, 0
    v_mov_b32 v71, 0
    v_mov_b32 v72, 0
    v_mov_b32 v73, 0
    v_mov_b32 v74, 0
    v_mov_b32 v75, 0
    v_mov_b32 v76, 0
    v_mov_b32 v77, 0
    v_mov_b32 v78, 0
    v_mov_b32 v79, 0
    v_mov_b32 v80, 0
    v_mov_b32 v81, 0
    v_mov_b32 v82, 0
    v_mov_b32 v83, 0
    v_mov_b32 v84, 0
    v_mov_b32 v85, 0
    v_mov_b32 v86, 0
    v_mov_b32 v87, 0
    v_mov_b32 v88, 0
    v_mov_b32 v89, 0
    v_mov_b32 v90, 0
    v_mov_b32 v91, 0
    v_mov_b32 v92, 0
    v_mov_b32 v93, 0
    v_mov_b32 v94, 0
    v_mov_b32 v95, 0
    v_mov_b32 v96, 0
    v_mov_b32 v97, 0
    v_mov_b32 v98, 0
    v_mov_b32 v99, 0
    v_mov_b32 v100, 0
    v_mov_b32 v101, 0
    v_mov_b32 v102, 0
    v_mov_b32 v103, 0
    v_mov_b32 v104, 0
    v_mov_b32 v105, 0
    v_mov_b32 v106, 0
    v_mov_b32 v107, 0
    v_mov_b32 v108, 0
    v_mov_b32 v109, 0
    v_mov_b32 v110, 0
    v_mov_b32 v111, 0
    s_cmp_ge_u32 s3, 8
    s_cbranch_scc1 L_b2
    s_and_b32 s54, s2, -16
    s_and_b32 s55, s2, 7
    s_lshl_b32 s55, s55, 1
    s_or_b32 s54, s54, s55
    s_bfe_u32 s55, s2, 0x10003
    s_or_b32 s54, s54, s55
    s_lshl_b32 s54, s54, 6
    s_add_u32 s48, s42, s54
    s_addc_u32 s49, s43, 0
    s_lshl_b32 s54, s3, 18
    v_lshrrev_b32 v28, 2, v1
    v_lshlrev_b32 v28, 14, v28
    v_and_b32 v29, 3, v1
    v_lshl_add_u32 v28, v29, 4, v28
    v_add_u32 v26, s54, v28
    s_mov_b64 s[62:63], -1
    s_cmp_ge_u32 s3, 5
    s_cselect_b32 s63, 0x0fffffff, s63
    s_mov_b32 s50, 0
    s_mov_b32 s78, 0
    s_lshl_b32 s54, s3, 8
    s_add_u32 s54, s54, 4194304
    v_mov_b32 v30, s54
    s_mov_b64 exec, 1
L_sent:
    global_load_dword v28, v30, s[42:43] sc1
    s_add_u32 s50, s50, 1
    s_waitcnt vmcnt(0)
    v_cmp_eq_u32 vcc, s37, v28
    s_cmp_gt_u32 s50, 20000
    s_cbranch_scc1 L_poll_fail
    s_cbranch_vccz L_sent
L_level:
    s_mov_b64 s[76:77], s[62:63]
L_poll:
    s_mov_b64 exec, s[76:77]
    global_load_dwordx4 v[32:35], v26, s[48:49] sc1
    s_add_u32 s50, s50, 1
    s_cmp_gt_u32 s50, 20000
    s_cbranch_scc1 L_poll_fail
    s_waitcnt vmcnt(0)
    v_xor_b32 v28, v20, v35
    v_and_b32 v28, v21, v28
    v_cmp_ne_u32 vcc, 0, v28
    s_lshr_b64 s[84:85], vcc, 1
    s_or_b64 s[84:85], s[84:85], vcc
    s_lshr_b64 s[86:87], s[84:85], 2
    s_or_b64 s[84:85], s[84:85], s[86:87]
    s_and_b32 s84, s84, 0x11111111
    s_and_b32 s85, s85, 0x11111111
    s_mul_i32 s76, s84, 15
    s_mul_i32 s77, s85, 15
    s_cmp_lg_u64 s[76:77], 0
    s_cbranch_scc1 L_poll
    s_mov_b64 exec, s[62:63]
    v_mov_b32 v31, 4
    s_movk_i32 s56, 96
    s_movk_i32 s57, 0x3fff
    s_movk_i32 s58, 0xfb
    v_bfe_u32 v36, v32, 6, 14
    v_lshlrev_b32 v42, 3, v32
    v_cmp_ne_u32 s[64:65], s57, v36
    v_bfe_u32 v28, v32, 4, 2
    v_and_b32 v42, 0x78, v42
    v_lshrrev_b32_e64 v28, v28, s58
    v_lshl_or_b32 v36, v36, 8, v28
    v_alignbit_b32 v29, v33, v32, 20
    v_bfe_u32 v37, v29, 6, 14
    v_lshlrev_b32 v43, 3, v29
    v_cmp_ne_u32 s[66:67], s57, v37
    v_bfe_u32 v28, v29, 4, 2
    v_and_b32 v43, 0x78, v43
    v_lshrrev_b32_e64 v28, v28, s58
    v_lshl_or_b32 v37, v37, 8, v28
    v_bfe_u32 v38, v33, 14, 14
    v_lshrrev_b32 v44, 5, v33
    v_cmp_ne_u32 s[68:69], s57, v38
    v_bfe_u32 v28, v33, 12, 2
    v_and_b32 v44, 0x78, v44
    v_lshrrev_b32_e64 v28, v28, s58
    v_lshl_or_b32 v38, v38, 8, v28
    v_alignbit_b32 v29, v34, v33, 28
    v_bfe_u32 v39, v29, 6, 14
    v_lshlrev_b32 v45, 3, v29
    v_cmp_ne_u32 s[70:71], s57, v39
    v_bfe_u32 v28, v29, 4, 2
    v_and_b32 v45, 0x78, v45
    v_lshrrev_b32_e64 v28, v28, s58
    v_lshl_or_b32 v39, v39, 8, v28
    v_alignbit_b32 v29, v35, v34, 16
    v_bfe_u32 v40, v29, 6, 14
    v_lshlrev_b32 v46, 3, v29
    v_cmp_ne_u32 s[72:73], s57, v40
    v_bfe_u32 v28, v29, 4, 2
    v_and_b32 v46, 0x78, v46
    v_lshrrev_b32_e64 v28, v28, s58
    v_lshl_or_b32 v40, v40, 8, v28
    v_bfe_u32 v41, v35, 10, 14
    v_lshrrev_b32 v47, 1, v35
    v_cmp_ne_u32 s[74:75], s57, v41
    v_bfe_u32 v28, v35, 8, 2
    v_and_b32 v47, 0x78, v47
    v_lshrrev_b32_e64 v28, v28, s58
    s_andn2_b64 s[74:75], s[74:75], s[60:61]
    v_lshl_or_b32 v41, v41, 8, v28
    s_mov_b64 exec, s[64:65]
    ds_add_rtn_u32 v48, v42, v31 offset:26560
    s_mov_b64 exec, s[66:67]
    ds_add_rtn_u32 v49, v43, v31 offset:26560
    s_mov_b64 exec, s[68:69]
    ds_add_rtn_u32 v50, v44, v31 offset:26560
    s_mov_b64 exec, s[70:71]
    ds_add_rtn_u32 v51, v45, v31 offset:26560
    s_mov_b64 exec, s[72:73]
    ds_add_rtn_u32 v52, v46, v31 offset:26560
    s_mov_b64 exec, s[74:75]
    ds_add_rtn_u32 v53, v47, v31 offset:26560
    s_waitcnt lgkmcnt(0)
    s_mov_b64 exec, s[64:65]
    v_min_u32 v28, 764, v48
    v_mad_u32_u24 v28, v42, s56, v28
    ds_write_b32 v28, v36 offset:0
    s_mov_b64 exec, s[66:67]
    v_min_u32 v28, 764, v49
    v_mad_u32_u24 v28, v43, s56, v28
    ds_write_b32 v28, v37 offset:0
    s_mov_b64 exec, s[68:69]
    v_min_u32 v28, 764, v50
    v_mad_u32_u24 v28, v44, s56, v28
    ds_write_b32 v28, v38 offset:0
    s_mov_b64 exec, s[70:71]
    v_min_u32 v28, 764, v51
    v_mad_u32_u24 v28, v45, s56, v28
    ds_write_b32 v28, v39 offset:0
    s_mov_b64 exec, s[72:73]
    v_min_u32 v28, 764, v52
    v_mad_u32_u24 v28, v46, s56, v28
    ds_write_b32 v28, v40 offset:0
    s_mov_b64 exec, s[74:75]
    v_min_u32 v28, 764, v53
    v_mad_u32_u24 v28, v47, s56, v28
    ds_write_b32 v28, v41 offset:0
    s_mov_b64 exec, -1
    s_cmp_lg_u32 s78, 0
    s_cbranch_scc1 L_lvl1_done
    s_and_b64 s[84:85], s[72:73], s[60:61]
    s_cmp_eq_u64 s[84:85], 0
    s_cbranch_scc1 L_b2
    s_lshr_b64 s[84:85], s[84:85], 3
    s_mul_i32 s62, s84, 15
    s_mul_i32 s63, s85, 15
    s_mov_b32 s78, 1
    v_add_u32 v26, 2097152, v26
    s_branch L_level
L_lvl1_done:
    s_and_b32 s84, s68, 0x22222222
    s_and_b32 s85, s69, 0x22222222
    s_cmp_eq_u64 s[84:85], 0
    s_cbranch_scc1 L_b2
L_poll_fail:
    s_mov_b64 exec, -1
    s_waitcnt vmcnt(0)
    v_mov_b32 v28, 0
    v_mov_b32 v29, 1
    ds_write_b32 v28, v29 offset:26688
    s_branch L_b2
.p2align 12
L_aux:
    s_cmp_ge_u32 s101, 128
    s_cbranch_scc1 L_aux_np
    v_lshrrev_b32 v28, 2, v0
    v_and_b32 v29, 1, v28
    v_bfe_u32 v30, v28, 1, 3
    v_and_b32 v28, -16, v28
    v_lshl_or_b32 v28, v29, 3, v28
    v_or_b32 v28, v28, v30
    v_and_b32 v29, 3, v0
    v_mul_u32_u24 v22, 24, v29
    s_movk_i32 s55, 136
    v_mad_u32_u24 v22, v28, s55, v22
    v_add_u32 v22, 26752, v22
    v_lshlrev_b32 v23, 2, v28
    s_lshl_b32 s54, s101, 14
    v_lshl_add_u32 v24, v0, 4, s54
    s_waitcnt vmcnt(0)
L_aux_tags:
    v_readfirstlane_b32 s40, v126
    s_xor_b32 s37, s40, 0x5bd1e995
    v_and_b32 v28, 3, v0
    v_mul_u32_u24 v28, 85, v28
    s_add_u32 s54, s40, 1
    v_add_u32 v28, s54, v28
    v_lshlrev_b32 v28, 24, v28
    s_xor_b32 s54, s40, 0x05a5a5a5
    s_lshl_b32 s54, s54, 4
    v_mov_b32 v29, s54
    v_cndmask_b32 v20, v28, v29, s[60:61]
    v_mov_b32 v28, 0xff000000
    v_mov_b32 v29, -16
    v_cndmask_b32 v21, v28, v29, s[60:61]
    s_branch L_wo_shared
L_aux_wo_done:
L_aux_np:
    s_cmp_lg_u32 s3, 10
    s_cbranch_scc1 L_aux_noe
    s_cmp_lt_u32 s101, 128
    s_cbranch_scc1 L_rep_p
    s_waitcnt vmcnt(0)
    v_readfirstlane_b32 s40, v126
    v_mov_b32 v28, 0
L_rep_spin:
    ds_read_b32 v29, v28 offset:26712
    s_waitcnt lgkmcnt(0)
    v_readfirstlane_b32 s54, v29
    s_cmp_lt_u32 s54, 8
    s_cbranch_scc1 L_rep_spin
    s_branch L_rep_st
L_rep_p:
    v_mov_b32 v28, 0
L_syrp:
    ds_read_b32 v29, v28 offset:26700
    s_waitcnt lgkmcnt(0)
    v_readfirstlane_b32 s54, v29
    s_and_b32 s54, s54, 65280
    s_cmp_lg_u32 s54, 4096
    s_cbranch_scc1 L_syrp
L_rep_st:
    s_xor_b32 s54, s40, 0x3c6ef372
    s_lshl_b32 s55, s2, 7
    s_add_u32 s55, s55, 4227072
    v_mov_b32 v28, s55
    v_mov_b32 v29, s54
    s_mov_b64 exec, 1
    global_store_dword v28, v29, s[42:43] sc1
    s_mov_b64 exec, -1
L_aux_noe:
    s_cmp_lg_u32 s3, 11
    s_cbranch_scc1 L_pfx_done
    s_cmp_lt_u32 s101, 128
    s_cbranch_scc1 L_pfx_done
    v_mov_b32 v123, 0
    s_lshr_b32 s54, s2, 4
    s_mul_i32 s54, s54, 1280
    s_and_b32 s55, s2, 7
    s_mul_i32 s55, s55, 80
    s_movk_i32 s56, 560
    s_movk_i32 s57, 256
L_pfl:
    v_add_u32 v28, s57, v1
    v_min_u32 v28, 1119, v28
    v_cmp_le_u32 vcc, s56, v28
    v_mov_b32 v29, 80
    v_cndmask_b32 v30, 0, v29, vcc
    v_mul_u32_u24 v31, 7, v30
    v_sub_u32 v31, v28, v31
    v_cmp_le_u32 vcc, s55, v31
    s_add_u32 s57, s57, 64
    s_nop 0
    v_cndmask_b32 v29, 0, v29, vcc
    v_add3_u32 v28, v28, v29, v30
    v_add_lshl_u32 v28, v28, s54, 7
    s_waitcnt vmcnt(0)
    ds_read_b32 v122, v123 offset:26700
    s_waitcnt lgkmcnt(0)
    v_readfirstlane_b32 s59, v122
    s_and_b32 s59, s59, 0xff
    s_cmp_ge_u32 s59, 1
    s_cbranch_scc1 L_pfx_done
    buffer_load_dword v127, v28, s[4:7], 0 offen
    s_cmp_lt_u32 s57, 1120
    s_cbranch_scc1 L_pfl
L_pfx_done:
    v_lshrrev_b32 v28, 2, v2
    s_movk_i32 s54, 1056
    v_mul_u32_u24 v29, s54, v28
    v_lshl_add_u32 v29, v7, 8, v29
    v_lshl_add_u32 v29, v3, 4, v29
    v_add_u32 v29, s41, v29
    v_xor_b32 v30, 0, v7
    v_lshl_add_u32 v8, v30, 6, v29
    v_xor_b32 v30, 1, v7
    v_lshl_add_u32 v9, v30, 6, v29
    v_xor_b32 v30, 2, v7
    v_lshl_add_u32 v10, v30, 6, v29
    v_xor_b32 v30, 3, v7
    v_lshl_add_u32 v11, v30, 6, v29
    v_and_b32 v29, 1, v3
    v_lshrrev_b32 v30, 1, v3
    v_lshl_add_u32 v29, v29, 2, v30
    v_mul_u32_u24 v29, s54, v29
    v_and_b32 v30, 1, v28
    v_lshl_add_u32 v29, v30, 5, v29
    v_lshl_add_u32 v29, v7, 3, v29
    v_lshrrev_b32 v31, 1, v28
    v_lshl_add_u32 v29, v31, 8, v29
    v_add_u32 v29, s41, v29
    v_xor_b32 v30, 0, v31
    v_lshl_add_u32 v12, v30, 6, v29
    v_xor_b32 v30, 1, v31
    v_lshl_add_u32 v13, v30, 6, v29
    v_xor_b32 v30, 2, v31
    v_lshl_add_u32 v14, v30, 6, v29
    v_xor_b32 v30, 3, v31
    v_lshl_add_u32 v15, v30, 6, v29
    s_mul_i32 s54, s3, 768
    v_and_b32 v29, 7, v2
    v_lshl_add_u32 v29, v29, 2, v3
    v_lshlrev_b32 v29, 2, v29
    v_add_u32 v5, s54, v29
    v_and_b32 v29, 1, v28
    v_lshlrev_b32 v30, 6, v29
    v_lshl_add_u32 v30, v3, 4, v30
    v_add_u32 v6, s54, v30
    v_lshrrev_b32 v30, 1, v3
    v_lshlrev_b32 v30, 7, v30
    v_lshl_add_u32 v30, v2, 3, v30
    s_mul_i32 s54, s3, 272
    v_add_u32 v16, s54, v30
    s_lshr_b32 s54, s3, 2
    s_lshl_b32 s54, s54, 3
    s_lshl_b32 s54, 1, s54
    v_mov_b32 v17, s54
    s_mov_b32 s44, 0xf0f0f0f0
    s_mov_b32 s45, 0xf0f0f0f0
    v_mov_b32 v64, 0
    v_mov_b32 v65, 0
    v_mov_b32 v66, 0
    v_mov_b32 v67, 0
    v_mov_b32 v68, 0
    v_mov_b32 v69, 0
    v_mov_b32 v70, 0
    v_mov_b32 v71, 0
    v_mov_b32 v72, 0
    v_mov_b32 v73, 0
    v_mov_b32 v74, 0
    v_mov_b32 v75, 0
    v_mov_b32 v76, 0
    v_mov_b32 v77, 0
    v_mov_b32 v78, 0
    v_mov_b32 v79, 0
    v_mov_b32 v80, 0
    v_mov_b32 v81, 0
    v_mov_b32 v82, 0
    v_mov_b32 v83, 0
    v_mov_b32 v84, 0
    v_mov_b32 v85, 0
    v_mov_b32 v86, 0
    v_mov_b32 v87, 0
    v_mov_b32 v88, 0
    v_mov_b32 v89, 0
    v_mov_b32 v90, 0
    v_mov_b32 v91, 0
    v_mov_b32 v92, 0
    v_mov_b32 v93, 0
    v_mov_b32 v94, 0
    v_mov_b32 v95, 0
    v_mov_b32 v96, 0
    v_mov_b32 v97, 0
    v_mov_b32 v98, 0
    v_mov_b32 v99, 0
    v_mov_b32 v100, 0
    v_mov_b32 v101, 0
    v_mov_b32 v102, 0
    v_mov_b32 v103, 0
    v_mov_b32 v104, 0
    v_mov_b32 v105, 0
    v_mov_b32 v106, 0
    v_mov_b32 v107, 0
    v_mov_b32 v108, 0
    v_mov_b32 v109, 0
    v_mov_b32 v110, 0
    v_mov_b32 v111, 0
    s_branch L_b2
L_qgemm:
    s_mov_b32 s24, s14
    s_mov_b32 s25, s15
    s_mov_b32 s26, 32768
    s_mov_b32 s27, 0x20000
    s_setprio 1
    s_cmp_ge_u32 s101, 128
    s_cbranch_scc1 L_qd_np
    v_lshrrev_b32 v28, 2, v0
    v_and_b32 v29, 1, v28
    v_bfe_u32 v30, v28, 1, 3
    v_and_b32 v28, -16, v28
    v_lshl_or_b32 v28, v29, 3, v28
    v_or_b32 v28, v28, v30
    v_and_b32 v29, 3, v0
    v_mul_u32_u24 v22, 24, v29
    s_movk_i32 s55, 136
    v_mad_u32_u24 v22, v28, s55, v22
    v_add_u32 v22, 26752, v22
    v_lshlrev_b32 v23, 2, v28
    s_lshl_b32 s54, s101, 14
    v_lshl_add_u32 v24, v0, 4, s54
    s_waitcnt vmcnt(0)
    v_readfirstlane_b32 s40, v126
    s_xor_b32 s37, s40, 0x5bd1e995
    v_and_b32 v28, 3, v0
    v_mul_u32_u24 v28, 85, v28
    s_add_u32 s54, s40, 1
    v_add_u32 v28, s54, v28
    v_lshlrev_b32 v28, 24, v28
    s_xor_b32 s54, s40, 0x05a5a5a5
    s_lshl_b32 s54, s54, 4
    v_mov_b32 v29, s54
    v_cndmask_b32 v20, v28, v29, s[60:61]
    v_mov_b32 v28, 0xff000000
    v_mov_b32 v29, -16
    v_cndmask_b32 v21, v28, v29, s[60:61]
    s_branch L_wo_shared
L_q_wo_done:
    s_mov_b32 s24, s14
    s_mov_b32 s25, s15
    s_mov_b32 s26, 32768
    s_mov_b32 s27, 0x20000
    v_mov_b32 v28, 0
L_syqw:
    ds_read_b32 v29, v28 offset:26700
    s_waitcnt lgkmcnt(0)
    v_readfirstlane_b32 s54, v29
    s_and_b32 s54, s54, 65280
    s_cmp_lg_u32 s54, 4096
    s_cbranch_scc1 L_syqw
    s_branch L_qd_go
L_qd_np:
    s_waitcnt vmcnt(0)
L_qd_go:
    s_sub_u32 s54, s3, 12
    v_lshl_add_u32 v28, v3, 8, v4
    s_mul_i32 s55, s2, 10240
    s_lshl_b32 s56, s54, 10
    s_add_u32 s55, s55, s56
    s_mul_i32 s56, s54, 1056
    s_add_u32 m0, s56, 60544
    s_nop 0
    buffer_load_dwordx4 v28, s[4:7], s55 offen lds
    s_add_u32 m0, m0, 4224
    s_add_u32 s55, s55, 4096
    buffer_load_dwordx4 v28, s[4:7], s55 offen lds
    s_cmp_ge_u32 s54, 2
    s_cbranch_scc1 L_q_x2
    s_add_u32 m0, m0, 4224
    s_add_u32 s55, s55, 4096
    buffer_load_dwordx4 v28, s[4:7], s55 offen lds
L_q_x2:
    s_lshl_b32 s55, s54, 13
    s_mov_b32 m0, s41
    s_nop 0
    buffer_load_dwordx4 v28, s[24:27], s55 offen lds
    s_add_u32 m0, m0, 1056
    s_add_u32 s55, s55, 1024
    buffer_load_dwordx4 v28, s[24:27], s55 offen lds
    s_add_u32 m0, m0, 1056
    s_add_u32 s55, s55, 1024
    buffer_load_dwordx4 v28, s[24:27], s55 offen lds
    s_add_u32 m0, m0, 1056
    s_add_u32 s55, s55, 1024
    buffer_load_dwordx4 v28, s[24:27], s55 offen lds
    s_add_u32 m0, m0, 1056
    s_add_u32 s55, s55, 1024
    buffer_load_dwordx4 v28, s[24:27], s55 offen lds
    s_add_u32 m0, m0, 1056
    s_add_u32 s55, s55, 1024
    buffer_load_dwordx4 v28, s[24:27], s55 offen lds
    s_add_u32 m0, m0, 1056
    s_add_u32 s55, s55, 1024
    buffer_load_dwordx4 v28, s[24:27], s55 offen lds
    s_add_u32 m0, m0, 1056
    s_add_u32 s55, s55, 1024
    buffer_load_dwordx4 v28, s[24:27], s55 offen lds
    s_waitcnt vmcnt(0)
L_q_w:
    v_mov_b32 v28, 0
    v_mov_b32 v29, 1
    s_mov_b64 exec, 1
    ds_add_u32 v28, v29 offset:26696
    s_mov_b64 exec, -1
    v_lshrrev_b32 v28, 2, v2
    s_movk_i32 s54, 1056
    v_mul_u32_u24 v29, s54, v28
    v_lshl_add_u32 v29, v7, 8, v29
    v_lshl_add_u32 v29, v3, 4, v29
    v_add_u32 v29, s41, v29
    v_xor_b32 v30, 0, v7
    v_lshl_add_u32 v8, v30, 6, v29
    v_xor_b32 v30, 1, v7
    v_lshl_add_u32 v9, v30, 6, v29
    v_xor_b32 v30, 2, v7
    v_lshl_add_u32 v10, v30, 6, v29
    v_xor_b32 v30, 3, v7
    v_lshl_add_u32 v11, v30, 6, v29
    v_and_b32 v29, 1, v3
    v_lshrrev_b32 v30, 1, v3
    v_lshl_add_u32 v29, v29, 2, v30
    v_mul_u32_u24 v29, s54, v29
    v_and_b32 v30, 1, v28
    v_lshl_add_u32 v29, v30, 5, v29
    v_lshl_add_u32 v29, v7, 3, v29
    v_lshrrev_b32 v31, 1, v28
    v_lshl_add_u32 v29, v31, 8, v29
    v_add_u32 v29, s41, v29
    v_xor_b32 v30, 0, v31
    v_lshl_add_u32 v12, v30, 6, v29
    v_xor_b32 v30, 1, v31
    v_lshl_add_u32 v13, v30, 6, v29
    v_xor_b32 v30, 2, v31
    v_lshl_add_u32 v14, v30, 6, v29
    v_xor_b32 v30, 3, v31
    v_lshl_add_u32 v15, v30, 6, v29
    s_mul_i32 s54, s3, 768
    v_and_b32 v29, 7, v2
    v_lshl_add_u32 v29, v29, 2, v3
    v_lshlrev_b32 v29, 2, v29
    v_add_u32 v5, s54, v29
    v_and_b32 v29, 1, v28
    v_lshlrev_b32 v30, 6, v29
    v_lshl_add_u32 v30, v3, 4, v30
    v_add_u32 v6, s54, v30
    v_lshrrev_b32 v30, 1, v3
    v_lshlrev_b32 v30, 7, v30
    v_lshl_add_u32 v30, v2, 3, v30
    s_mul_i32 s54, s3, 272
    v_add_u32 v16, s54, v30
    s_lshr_b32 s54, s3, 2
    s_lshl_b32 s54, s54, 3
    s_lshl_b32 s54, 1, s54
    v_mov_b32 v17, s54
    s_mov_b32 s44, 0xf0f0f0f0
    s_mov_b32 s45, 0xf0f0f0f0
    v_subrev_u32 v122, s41, v8
    v_add_u32 v122, 60544, v122
    v_subrev_u32 v123, s41, v9
    v_add_u32 v123, 60544, v123
    v_subrev_u32 v124, s41, v10
    v_add_u32 v124, 60544, v124
    v_subrev_u32 v125, s41, v11
    v_add_u32 v125, 60544, v125
    v_mov_b32 v28, 0
L_qspinq:
    ds_read_b32 v29, v28 offset:26696
    s_waitcnt lgkmcnt(0)
    v_readfirstlane_b32 s54, v29
    s_cmp_lt_u32 s54, 4
    s_cbranch_scc1 L_qspinq
    s_movk_i32 s55, 2112
    v_mul_u32_u24 v28, s55, v3
    v_lshrrev_b32 v29, 2, v2
    v_lshl_add_u32 v28, v29, 8, v28
    s_sub_u32 s54, s3, 12
    v_xor_b32 v29, s54, v29
    v_lshl_add_u32 v28, v29, 6, v28
    v_lshl_add_u32 v28, v7, 4, v28
    v_add_u32 v28, 128128, v28
    ds_read_b64_tr_b16 v[32:33], v28 offset:0
    ds_read_b64_tr_b16 v[34:35], v28 offset:1056
    ds_read_b64_tr_b16 v[48:49], v28 offset:8
    ds_read_b64_tr_b16 v[50:51], v28 offset:1064
    ds_read_b64_tr_b16 v[36:37], v28 offset:8448
    ds_read_b64_tr_b16 v[38:39], v28 offset:9504
    ds_read_b64_tr_b16 v[52:53], v28 offset:8456
    ds_read_b64_tr_b16 v[54:55], v28 offset:9512
    ds_read_b64_tr_b16 v[40:41], v28 offset:16896
    ds_read_b64_tr_b16 v[42:43], v28 offset:17952
    ds_read_b64_tr_b16 v[56:57], v28 offset:16904
    ds_read_b64_tr_b16 v[58:59], v28 offset:17960
    ds_read_b64_tr_b16 v[44:45], v28 offset:25344
    ds_read_b64_tr_b16 v[46:47], v28 offset:26400
    ds_read_b64_tr_b16 v[60:61], v28 offset:25352
    ds_read_b64_tr_b16 v[62:63], v28 offset:26408
    ds_read_b128 v[64:67], v122 offset:0
    ds_read_b128 v[68:71], v123 offset:0
    ds_read_b128 v[72:75], v124 offset:0
    ds_read_b128 v[76:79], v125 offset:0
    ds_read_b128 v[80:83], v122 offset:4224
    ds_read_b128 v[84:87], v123 offset:4224
    ds_read_b128 v[88:91], v124 offset:4224
    ds_read_b128 v[92:95], v125 offset:4224
    v_lshrrev_b32 v29, 3, v2
    s_movk_i32 s55, 2112
    v_mul_u32_u24 v29, s55, v29
    v_sub_u32 v122, v122, v29
    v_sub_u32 v123, v123, v29
    v_sub_u32 v124, v124, v29
    v_sub_u32 v125, v125, v29
    ds_read_b128 v[96:99], v122 offset:8448
    ds_read_b128 v[100:103], v123 offset:8448
    ds_read_b128 v[104:107], v124 offset:8448
    ds_read_b128 v[108:111], v125 offset:8448
    s_sub_u32 s54, s3, 12
    s_lshl_b32 s54, s54, 6
    s_movk_i32 s55, 272
    v_mul_u32_u24 v28, s55, v2
    v_lshl_add_u32 v28, v3, 4, v28
    v_add_u32 v28, s54, v28
    s_mov_b32 s56, 0xbe0293ee
    s_waitcnt lgkmcnt(8)
    v_mfma_f32_16x16x32_bf16 v[112:115], v[32:35], v[64:67], 0
    v_mfma_f32_16x16x32_bf16 v[116:119], v[48:51], v[64:67], 0
    v_mfma_f32_16x16x32_bf16 v[112:115], v[36:39], v[68:71], v[112:115]
    v_mfma_f32_16x16x32_bf16 v[116:119], v[52:55], v[68:71], v[116:119]
    v_mfma_f32_16x16x32_bf16 v[112:115], v[40:43], v[72:75], v[112:115]
    v_mfma_f32_16x16x32_bf16 v[116:119], v[56:59], v[72:75], v[116:119]
    v_mfma_f32_16x16x32_bf16 v[112:115], v[44:47], v[76:79], v[112:115]
    v_mfma_f32_16x16x32_bf16 v[116:119], v[60:63], v[76:79], v[116:119]
    s_waitcnt lgkmcnt(4)
    v_mfma_f32_16x16x32_bf16 v[20:23], v[32:35], v[80:83], 0
    v_mfma_f32_16x16x32_bf16 v[24:27], v[48:51], v[80:83], 0
    v_mfma_f32_16x16x32_bf16 v[20:23], v[36:39], v[84:87], v[20:23]
    v_mfma_f32_16x16x32_bf16 v[24:27], v[52:55], v[84:87], v[24:27]
    v_mfma_f32_16x16x32_bf16 v[20:23], v[40:43], v[88:91], v[20:23]
    v_mfma_f32_16x16x32_bf16 v[24:27], v[56:59], v[88:91], v[24:27]
    v_mfma_f32_16x16x32_bf16 v[20:23], v[44:47], v[92:95], v[20:23]
    v_mfma_f32_16x16x32_bf16 v[24:27], v[60:63], v[92:95], v[24:27]
    s_waitcnt lgkmcnt(0)
    v_mfma_f32_16x16x32_bf16 v[64:67], v[32:35], v[96:99], 0
    v_mfma_f32_16x16x32_bf16 v[68:71], v[48:51], v[96:99], 0
    v_mfma_f32_16x16x32_bf16 v[64:67], v[36:39], v[100:103], v[64:67]
    v_mfma_f32_16x16x32_bf16 v[68:71], v[52:55], v[100:103], v[68:71]
    v_mfma_f32_16x16x32_bf16 v[64:67], v[40:43], v[104:107], v[64:67]
    v_mfma_f32_16x16x32_bf16 v[68:71], v[56:59], v[104:107], v[68:71]
    v_mfma_f32_16x16x32_bf16 v[64:67], v[44:47], v[108:111], v[64:67]
    v_mfma_f32_16x16x32_bf16 v[68:71], v[60:63], v[108:111], v[68:71]
    v_mul_f32 v112, s56, v112
    v_mul_f32 v113, s56, v113
    v_mul_f32 v114, s56, v114
    v_mul_f32 v115, s56, v115
    v_mul_f32 v116, s56, v116
    v_mul_f32 v117, s56, v117
    v_mul_f32 v118, s56, v118
    v_mul_f32 v119, s56, v119
    v_cvt_pk_bf16_f32 v112, v112, v113
    v_cvt_pk_bf16_f32 v113, v114, v115
    v_cvt_pk_bf16_f32 v114, v116, v117
    v_cvt_pk_bf16_f32 v115, v118, v119
    ds_write_b128 v28, v[112:115] offset:12288
    v_mul_f32 v20, s56, v20
    v_mul_f32 v21, s56, v21
    v_mul_f32 v22, s56, v22
    v_mul_f32 v23, s56, v23
    v_mul_f32 v24, s56, v24
    v_mul_f32 v25, s56, v25
    v_mul_f32 v26, s56, v26
    v_mul_f32 v27, s56, v27
    v_cvt_pk_bf16_f32 v20, v20, v21
    v_cvt_pk_bf16_f32 v21, v22, v23
    v_cvt_pk_bf16_f32 v22, v24, v25
    v_cvt_pk_bf16_f32 v23, v26, v27
    ds_write_b128 v28, v[20:23] offset:16688
    s_nop 3
    v_mul_f32 v64, s56, v64
    v_mul_f32 v65, s56, v65
    v_mul_f32 v66, s56, v66
    v_mul_f32 v67, s56, v67
    v_mul_f32 v68, s56, v68
    v_mul_f32 v69, s56, v69
    v_mul_f32 v70, s56, v70
    v_mul_f32 v71, s56, v71
    v_cvt_pk_bf16_f32 v64, v64, v65
    v_cvt_pk_bf16_f32 v65, v66, v67
    v_cvt_pk_bf16_f32 v66, v68, v69
    v_cvt_pk_bf16_f32 v67, v70, v71
    ds_write_b128 v28, v[64:67] offset:21088
    v_mov_b32 v28, 0
    v_mov_b32 v29, 0x10000
    s_mov_b64 exec, 1
    s_waitcnt lgkmcnt(0)
    ds_add_u32 v28, v29 offset:26700
    s_mov_b64 exec, -1
    s_setprio 0
    s_nop 1
    v_mov_b32 v64, 0
    v_mov_b32 v65, 0
    v_mov_b32 v66, 0
    v_mov_b32 v67, 0
    v_mov_b32 v68, 0
    v_mov_b32 v69, 0
    v_mov_b32 v70, 0
    v_mov_b32 v71, 0
    v_mov_b32 v72, 0
    v_mov_b32 v73, 0
    v_mov_b32 v74, 0
    v_mov_b32 v75, 0
    v_mov_b32 v76, 0
    v_mov_b32 v77, 0
    v_mov_b32 v78, 0
    v_mov_b32 v79, 0
    v_mov_b32 v80, 0
    v_mov_b32 v81, 0
    v_mov_b32 v82, 0
    v_mov_b32 v83, 0
    v_mov_b32 v84, 0
    v_mov_b32 v85, 0
    v_mov_b32 v86, 0
    v_mov_b32 v87, 0
    v_mov_b32 v88, 0
    v_mov_b32 v89, 0
    v_mov_b32 v90, 0
    v_mov_b32 v91, 0
    v_mov_b32 v92, 0
    v_mov_b32 v93, 0
    v_mov_b32 v94, 0
    v_mov_b32 v95, 0
    v_mov_b32 v96, 0
    v_mov_b32 v97, 0
    v_mov_b32 v98, 0
    v_mov_b32 v99, 0
    v_mov_b32 v100, 0
    v_mov_b32 v101, 0
    v_mov_b32 v102, 0
    v_mov_b32 v103, 0
    v_mov_b32 v104, 0
    v_mov_b32 v105, 0
    v_mov_b32 v106, 0
    v_mov_b32 v107, 0
    v_mov_b32 v108, 0
    v_mov_b32 v109, 0
    v_mov_b32 v110, 0
    v_mov_b32 v111, 0
    s_branch L_b2
.p2align 12
L_b2:
    s_waitcnt lgkmcnt(0)
    s_mov_b32 s80, 0xff
    s_mov_b32 s81, 8
    s_cmp_ge_u32 s3, 8
    s_cbranch_scc1 L_sy_noadd
    v_mov_b32 v28, 0
    v_mov_b32 v29, 1
    s_mov_b64 exec, 1
    ds_add_u32 v28, v29 offset:26700
    s_mov_b64 exec, -1
L_sy_noadd:
    s_lshl_b32 s54, 1, s3
    s_and_b32 s55, s54, 0xf030
    s_cselect_b32 s55, 0xff0000, 0
    s_or_b32 s80, s80, s55
    s_and_b32 s55, s55, 262144
    s_or_b32 s81, s81, s55
    s_and_b32 s55, s54, 0x040f
    s_cselect_b32 s55, 0xff00, 0
    s_cmp_lt_u32 s101, 128
    s_cselect_b32 s55, s55, 0
    s_or_b32 s80, s80, s55
    s_and_b32 s55, s55, 4096
    s_or_b32 s81, s81, s55
    s_cmp_eq_u32 s3, 10
    s_cselect_b32 s38, 1, 0
    s_mov_b32 s39, 0
    v_mov_b32 v28, 0
L_syb2:
    ds_read_b32 v29, v28 offset:26700
    s_waitcnt lgkmcnt(0)
    v_readfirstlane_b32 s54, v29
    s_and_b32 s54, s54, s80
    s_cmp_lg_u32 s54, s81
    s_cbranch_scc1 L_syb2
    s_lshl_b32 s54, s3, 3
    v_mov_b32 v29, s54
    v_mov_b32 v30, 0
    ds_read_b32 v19, v5 offset:0
    ds_read_b32 v122, v29 offset:26560
    ds_read_b32 v123, v30 offset:26688
    s_waitcnt lgkmcnt(0)
    v_readfirstlane_b32 s50, v122
    v_readfirstlane_b32 s54, v123
    s_mov_b32 s52, 0
    s_lshr_b32 s50, s50, 2
    s_cmp_gt_u32 s50, 192
    s_cselect_b32 s53, 1, 0
    s_or_b32 s53, s53, s54
    s_cmp_eq_u32 s53, 0
    s_cbranch_scc0 L_slow
L_main:
    s_add_u32 s51, s50, 31
    s_lshr_b32 s51, s51, 5
    s_mov_b32 s46, s50
    v_mov_b32 v120, v5
    v_mov_b32 v121, v6
    s_waitcnt lgkmcnt(0)
    s_cmp_eq_u32 s51, 0
    s_cbranch_scc1 L_main_zero
    s_setprio 3
    v_and_b32 v18, 0x3fff00, v19
    s_mov_b32 m0, s41
    s_nop 0
    v_add_u32_dpp v28, v18, v4 row_newbcast:0 row_mask:0xf bank_mask:0xf
    buffer_load_dwordx4 v28, s[4:7], 0 offen lds
    s_add_u32 m0, m0, 1056
    v_add_u32_dpp v28, v18, v4 row_newbcast:1 row_mask:0xf bank_mask:0xf
    buffer_load_dwordx4 v28, s[4:7], 0 offen lds
    s_add_u32 m0, m0, 1056
    v_add_u32_dpp v28, v18, v4 row_newbcast:2 row_mask:0xf bank_mask:0xf
    buffer_load_dwordx4 v28, s[4:7], 0 offen lds
    s_add_u32 m0, m0, 1056
    v_add_u32_dpp v28, v18, v4 row_newbcast:3 row_mask:0xf bank_mask:0xf
    buffer_load_dwordx4 v28, s[4:7], 0 offen lds
    s_add_u32 m0, m0, 1056
    v_add_u32_dpp v28, v18, v4 row_newbcast:4 row_mask:0xf bank_mask:0xf
    buffer_load_dwordx4 v28, s[4:7], 0 offen lds
    s_add_u32 m0, m0, 1056
    v_add_u32_dpp v28, v18, v4 row_newbcast:5 row_mask:0xf bank_mask:0xf
    buffer_load_dwordx4 v28, s[4:7], 0 offen lds
    s_add_u32 m0, m0, 1056
    v_add_u32_dpp v28, v18, v4 row_newbcast:6 row_mask:0xf bank_mask:0xf
    buffer_load_dwordx4 v28, s[4:7], 0 offen lds
    s_add_u32 m0, m0, 1056
    v_add_u32_dpp v28, v18, v4 row_newbcast:7 row_mask:0xf bank_mask:0xf
    buffer_load_dwordx4 v28, s[4:7], 0 offen lds
    v_mov_b32 v28, 0xdddddddd
    v_mov_b32 v116, 0x88888888
    v_cmp_gt_u32 vcc, 8, v2
    v_sub_u32 v117, 2, v7
    v_and_b32 v117, 3, v117
    v_cndmask_b32 v116, v28, v116, vcc
    s_cmp_lg_u32 s39, 0
    s_cbranch_scc1 L_grp
    v_mov_b32 v28, 0
L_syqm:
    ds_read_b32 v29, v28 offset:26700
    s_waitcnt lgkmcnt(0)
    v_readfirstlane_b32 s54, v29
    s_and_b32 s54, s54, 16711680
    s_cmp_lg_u32 s54, 262144
    s_cbranch_scc1 L_syqm
    s_mul_i32 s54, s3, 272
    s_movk_i32 s55, 4400
    v_mul_u32_u24 v28, s55, v7
    v_lshl_add_u32 v28, v3, 4, v28
    v_add_u32 v28, s54, v28
    s_mov_b32 exec_lo, 0x0f0f0f0f
    s_mov_b32 exec_hi, 0x0f0f0f0f
    ds_read_b128 v[96:99], v28 offset:12288
    ds_read_b128 v[100:103], v28 offset:12352
    ds_read_b128 v[104:107], v28 offset:12416
    ds_read_b128 v[108:111], v28 offset:12480
    s_mov_b32 exec_lo, 0xf0f0f0f0
    s_mov_b32 exec_hi, 0xf0f0f0f0
    ds_read_b128 v[80:83], v28 offset:12288
    ds_read_b128 v[84:87], v28 offset:12352
    ds_read_b128 v[88:91], v28 offset:12416
    ds_read_b128 v[92:95], v28 offset:12480
    s_mov_b64 exec, -1
    s_mov_b32 s39, 1
L_grp:
    s_cmp_lt_u32 s3, 12
    s_cbranch_scc1 L_prn
    s_branch L_pr3
L_prn:
    s_cmp_ge_u32 s51, 4
    s_cbranch_scc1 L_pr3
    s_cmp_eq_u32 s51, 3
    s_cbranch_scc1 L_pr2
    s_cmp_eq_u32 s51, 2
    s_cbranch_scc1 L_pr1
    s_setprio 0
    s_branch L_prd
L_pr1:
    s_setprio 1
    s_branch L_prd
L_pr2:
    s_setprio 2
    s_branch L_prd
L_pr3:
    s_setprio 3
L_prd:
    s_waitcnt vmcnt(0)
    ds_read_b32 v19, v120 offset:128
    ds_read_b128 v[20:23], v121 offset:0
    ds_read_b128 v[32:35], v8 offset:0
    ds_read_b128 v[36:39], v8 offset:4224
    ds_read_b128 v[40:43], v9 offset:0
    ds_read_b128 v[44:47], v9 offset:4224
    ds_read_b128 v[48:51], v10 offset:0
    ds_read_b128 v[52:55], v10 offset:4224
    ds_read_b128 v[56:59], v11 offset:0
    ds_read_b128 v[60:63], v11 offset:4224
    s_waitcnt lgkmcnt(8)
    v_bfe_i32 v20, v20, v117, 1
    v_bfe_i32 v21, v21, v117, 1
    v_bfe_i32 v22, v22, v117, 1
    v_bfe_i32 v23, v23, v117, 1
    s_waitcnt lgkmcnt(6)
    s_nop 0
    v_mfma_f32_16x16x32_bf16 v[112:115], v[32:35], v[96:99], v[20:23]
    v_mfma_f32_16x16x32_bf16 v[112:115], v[36:39], v[80:83], v[112:115]
    ds_read_b64_tr_b16 v[32:33], v12 offset:0
    ds_read_b64_tr_b16 v[34:35], v14 offset:512
    ds_read_b64_tr_b16 v[36:37], v12 offset:2112
    ds_read_b64_tr_b16 v[38:39], v14 offset:2624
    s_waitcnt lgkmcnt(8)
    v_mfma_f32_16x16x32_bf16 v[112:115], v[40:43], v[100:103], v[112:115]
    v_mfma_f32_16x16x32_bf16 v[112:115], v[44:47], v[84:87], v[112:115]
    ds_read_b64_tr_b16 v[40:41], v13 offset:0
    ds_read_b64_tr_b16 v[42:43], v15 offset:512
    ds_read_b64_tr_b16 v[44:45], v13 offset:2112
    ds_read_b64_tr_b16 v[46:47], v15 offset:2624
    s_waitcnt lgkmcnt(10)
    v_mfma_f32_16x16x32_bf16 v[112:115], v[48:51], v[104:107], v[112:115]
    v_mfma_f32_16x16x32_bf16 v[112:115], v[52:55], v[88:91], v[112:115]
    ds_read_b64_tr_b16 v[48:49], v14 offset:0
    ds_read_b64_tr_b16 v[50:51], v12 offset:512
    ds_read_b64_tr_b16 v[52:53], v14 offset:2112
    ds_read_b64_tr_b16 v[54:55], v12 offset:2624
    s_waitcnt lgkmcnt(12)
    v_mfma_f32_16x16x32_bf16 v[112:115], v[56:59], v[108:111], v[112:115]
    v_mfma_f32_16x16x32_bf16 v[112:115], v[60:63], v[92:95], v[112:115]
    ds_read_b64_tr_b16 v[56:57], v15 offset:0
    ds_read_b64_tr_b16 v[58:59], v13 offset:512
    ds_read_b64_tr_b16 v[60:61], v15 offset:2112
    ds_read_b64_tr_b16 v[62:63], v13 offset:2624
    v_add_u32 v120, 128, v120
    v_add_u32 v121, 128, v121
    s_sub_u32 s51, s51, 1
    s_sub_u32 s46, s46, 32
    s_waitcnt lgkmcnt(0)
    s_cmp_eq_u32 s51, 0
    s_cbranch_scc1 L_lastgrp
    s_cmp_lt_u32 s46, 29
    s_cbranch_scc1 L_dma_part
    v_and_b32 v18, 0x3fff00, v19
    s_mov_b32 m0, s41
    s_nop 0
    v_add_u32_dpp v28, v18, v4 row_newbcast:0 row_mask:0xf bank_mask:0xf
    buffer_load_dwordx4 v28, s[4:7], 0 offen lds
    s_add_u32 m0, m0, 1056
    v_add_u32_dpp v28, v18, v4 row_newbcast:1 row_mask:0xf bank_mask:0xf
    buffer_load_dwordx4 v28, s[4:7], 0 offen lds
    s_add_u32 m0, m0, 1056
    v_add_u32_dpp v28, v18, v4 row_newbcast:2 row_mask:0xf bank_mask:0xf
    buffer_load_dwordx4 v28, s[4:7], 0 offen lds
    s_add_u32 m0, m0, 1056
    v_add_u32_dpp v28, v18, v4 row_newbcast:3 row_mask:0xf bank_mask:0xf
    buffer_load_dwordx4 v28, s[4:7], 0 offen lds
    s_add_u32 m0, m0, 1056
    v_add_u32_dpp v28, v18, v4 row_newbcast:4 row_mask:0xf bank_mask:0xf
    buffer_load_dwordx4 v28, s[4:7], 0 offen lds
    s_add_u32 m0, m0, 1056
    v_add_u32_dpp v28, v18, v4 row_newbcast:5 row_mask:0xf bank_mask:0xf
    buffer_load_dwordx4 v28, s[4:7], 0 offen lds
    s_add_u32 m0, m0, 1056
    v_add_u32_dpp v28, v18, v4 row_newbcast:6 row_mask:0xf bank_mask:0xf
    buffer_load_dwordx4 v28, s[4:7], 0 offen lds
    s_add_u32 m0, m0, 1056
    v_add_u32_dpp v28, v18, v4 row_newbcast:7 row_mask:0xf bank_mask:0xf
    buffer_load_dwordx4 v28, s[4:7], 0 offen lds
    s_branch L_skipdma
L_dma_part:
    v_and_b32 v18, 0x3fff00, v19
    s_mov_b32 m0, s41
    s_nop 0
    v_add_u32_dpp v28, v18, v4 row_newbcast:0 row_mask:0xf bank_mask:0xf
    buffer_load_dwordx4 v28, s[4:7], 0 offen lds
    s_cmp_le_u32 s46, 4
    s_cbranch_scc1 L_skipdma
    s_add_u32 m0, m0, 1056
    v_add_u32_dpp v28, v18, v4 row_newbcast:1 row_mask:0xf bank_mask:0xf
    buffer_load_dwordx4 v28, s[4:7], 0 offen lds
    s_cmp_le_u32 s46, 8
    s_cbranch_scc1 L_skipdma
    s_add_u32 m0, m0, 1056
    v_add_u32_dpp v28, v18, v4 row_newbcast:2 row_mask:0xf bank_mask:0xf
    buffer_load_dwordx4 v28, s[4:7], 0 offen lds
    s_cmp_le_u32 s46, 12
    s_cbranch_scc1 L_skipdma
    s_add_u32 m0, m0, 1056
    v_add_u32_dpp v28, v18, v4 row_newbcast:3 row_mask:0xf bank_mask:0xf
    buffer_load_dwordx4 v28, s[4:7], 0 offen lds
    s_cmp_le_u32 s46, 16
    s_cbranch_scc1 L_skipdma
    s_add_u32 m0, m0, 1056
    v_add_u32_dpp v28, v18, v4 row_newbcast:4 row_mask:0xf bank_mask:0xf
    buffer_load_dwordx4 v28, s[4:7], 0 offen lds
    s_cmp_le_u32 s46, 20
    s_cbranch_scc1 L_skipdma
    s_add_u32 m0, m0, 1056
    v_add_u32_dpp v28, v18, v4 row_newbcast:5 row_mask:0xf bank_mask:0xf
    buffer_load_dwordx4 v28, s[4:7], 0 offen lds
    s_cmp_le_u32 s46, 24
    s_cbranch_scc1 L_skipdma
    s_add_u32 m0, m0, 1056
    v_add_u32_dpp v28, v18, v4 row_newbcast:6 row_mask:0xf bank_mask:0xf
    buffer_load_dwordx4 v28, s[4:7], 0 offen lds
    s_cmp_le_u32 s46, 28
    s_cbranch_scc1 L_skipdma
    s_add_u32 m0, m0, 1056
    v_add_u32_dpp v28, v18, v4 row_newbcast:7 row_mask:0xf bank_mask:0xf
    buffer_load_dwordx4 v28, s[4:7], 0 offen lds
    s_branch L_skipdma
L_lastgrp:
    s_cmp_lt_u32 s3, 12
    s_cbranch_scc1 L_skipdma
    s_cmp_lg_u32 s53, 0
    s_cbranch_scc1 L_skipdma
    s_mov_b32 s28, s16
    s_mov_b32 s29, s17
    s_mov_b32 s30, 32768
    s_mov_b32 s31, 0x20000
    s_sub_u32 s54, s3, 12
    v_lshrrev_b32 v28, 2, v1
    v_lshlrev_b32 v28, 8, v28
    v_and_b32 v29, 3, v1
    v_lshlrev_b32 v29, 4, v29
    s_lshl_b32 s55, s54, 6
    v_add3_u32 v28, v28, v29, s55
    s_mov_b32 m0, s41
    s_mov_b32 s55, 0
    s_nop 0
    buffer_load_dwordx4 v28, s[28:31], s55 offen lds
    s_add_u32 m0, m0, 1056
    s_add_u32 s55, s55, 4096
    buffer_load_dwordx4 v28, s[28:31], s55 offen lds
    s_add_u32 m0, m0, 1056
    s_add_u32 s55, s55, 4096
    buffer_load_dwordx4 v28, s[28:31], s55 offen lds
    s_add_u32 m0, m0, 1056
    s_add_u32 s55, s55, 4096
    buffer_load_dwordx4 v28, s[28:31], s55 offen lds
    s_add_u32 m0, m0, 1056
    s_add_u32 s55, s55, 4096
    buffer_load_dwordx4 v28, s[28:31], s55 offen lds
    s_add_u32 m0, m0, 1056
    s_add_u32 s55, s55, 4096
    buffer_load_dwordx4 v28, s[28:31], s55 offen lds
    s_add_u32 m0, m0, 1056
    s_add_u32 s55, s55, 4096
    buffer_load_dwordx4 v28, s[28:31], s55 offen lds
    s_add_u32 m0, m0, 1056
    s_add_u32 s55, s55, 4096
    buffer_load_dwordx4 v28, s[28:31], s55 offen lds
    s_mov_b32 s47, 1
L_skipdma:
    s_nop 1
    v_exp_f32 v112, v112
    v_exp_f32 v113, v113
    v_exp_f32 v114, v114
    v_exp_f32 v115, v115
    s_nop 0
    v_add_f32 v112, 1.0, v112
    v_add_f32 v113, 1.0, v113
    v_add_f32 v114, 1.0, v114
    v_add_f32 v115, 1.0, v115
    v_rcp_f32_e64 v112, v112 clamp
    v_rcp_f32_e64 v113, v113 clamp
    v_rcp_f32_e64 v114, v114 clamp
    v_rcp_f32_e64 v115, v115 clamp
    s_nop 0
    v_cvt_pk_bf16_f32 v24, v112, v113
    v_cvt_pk_bf16_f32 v25, v114, v115
    s_nop 1
    v_mov_b32_dpp v26, v24 row_shl:4 row_mask:0xf bank_mask:0xf bound_ctrl:0
    v_mov_b32_dpp v27, v25 row_shl:4 row_mask:0xf bank_mask:0xf bound_ctrl:0
    s_nop 1
    v_smfmac_f32_16x16x64_bf16 v[64:67], v[24:27], v[32:39], v116
    v_smfmac_f32_16x16x64_bf16 v[68:71], v[24:27], v[40:47], v116
    v_smfmac_f32_16x16x64_bf16 v[72:75], v[24:27], v[48:55], v116
    v_smfmac_f32_16x16x64_bf16 v[76:79], v[24:27], v[56:63], v116
L_noC:
    s_cmp_lg_u32 s51, 0
    s_cbranch_scc1 L_grp
    s_branch L_main_done
L_main_zero:
    v_mov_b32 v28, 0
L_syqz:
    ds_read_b32 v29, v28 offset:26700
    s_waitcnt lgkmcnt(0)
    v_readfirstlane_b32 s54, v29
    s_and_b32 s54, s54, 16711680
    s_cmp_lg_u32 s54, 262144
    s_cbranch_scc1 L_syqz
L_main_done:
    s_cmp_eq_u32 s53, 0
    s_cbranch_scc1 L_epi
    s_cmp_lt_u32 s52, 320000
    s_cbranch_scc1 L_fill
L_epi:
    s_setprio 0
    s_nop 1
    v_cvt_pk_bf16_f32 v112, v64, v68
    v_cvt_pk_bf16_f32 v114, v65, v69
    v_cvt_pk_bf16_f32 v20, v66, v70
    v_cvt_pk_bf16_f32 v113, v72, v76
    v_cvt_pk_bf16_f32 v115, v73, v77
    v_cvt_pk_bf16_f32 v21, v74, v78
    s_mov_b32 exec_lo, 0x0000ffff
    s_mov_b32 exec_hi, 0x0000ffff
    ds_write_b64 v16, v[112:113] offset:12288
    ds_write_b64 v16, v[114:115] offset:16688
    ds_write_b64 v16, v[20:21] offset:21088
    s_mov_b64 exec, -1
    s_mov_b64 exec, 1
    ds_add_u32 v1, v17 offset:26708
    s_mov_b64 exec, -1
    s_cmp_lt_u32 s3, 12
    s_cbranch_scc1 L_b3
    s_setprio 3
    s_cmp_lg_u32 s47, 0
    s_cbranch_scc1 L_havewv
    s_mov_b32 s28, s16
    s_mov_b32 s29, s17
    s_mov_b32 s30, 32768
    s_mov_b32 s31, 0x20000
    s_sub_u32 s54, s3, 12
    v_lshrrev_b32 v28, 2, v1
    v_lshlrev_b32 v28, 8, v28
    v_and_b32 v29, 3, v1
    v_lshlrev_b32 v29, 4, v29
    s_lshl_b32 s55, s54, 6
    v_add3_u32 v28, v28, v29, s55
    s_mov_b32 m0, s41
    s_mov_b32 s55, 0
    s_nop 0
    buffer_load_dwordx4 v28, s[28:31], s55 offen lds
    s_add_u32 m0, m0, 1056
    s_add_u32 s55, s55, 4096
    buffer_load_dwordx4 v28, s[28:31], s55 offen lds
    s_add_u32 m0, m0, 1056
    s_add_u32 s55, s55, 4096
    buffer_load_dwordx4 v28, s[28:31], s55 offen lds
    s_add_u32 m0, m0, 1056
    s_add_u32 s55, s55, 4096
    buffer_load_dwordx4 v28, s[28:31], s55 offen lds
    s_add_u32 m0, m0, 1056
    s_add_u32 s55, s55, 4096
    buffer_load_dwordx4 v28, s[28:31], s55 offen lds
    s_add_u32 m0, m0, 1056
    s_add_u32 s55, s55, 4096
    buffer_load_dwordx4 v28, s[28:31], s55 offen lds
    s_add_u32 m0, m0, 1056
    s_add_u32 s55, s55, 4096
    buffer_load_dwordx4 v28, s[28:31], s55 offen lds
    s_add_u32 m0, m0, 1056
    s_add_u32 s55, s55, 4096
    buffer_load_dwordx4 v28, s[28:31], s55 offen lds
L_havewv:
    s_mov_b32 s32, s18
    s_mov_b32 s33, s19
    s_mov_b32 s34, 2560000
    s_mov_b32 s35, 0x20000
    s_waitcnt vmcnt(0)
    v_lshrrev_b32 v28, 2, v2
    s_movk_i32 s55, 2112
    v_mul_u32_u24 v28, s55, v28
    v_lshl_add_u32 v28, v3, 7, v28
    v_lshl_add_u32 v28, v7, 4, v28
    v_add_u32 v28, s41, v28
    ds_read_b64_tr_b16 v[32:33], v28 offset:0
    ds_read_b64_tr_b16 v[34:35], v28 offset:64
    ds_read_b64_tr_b16 v[48:49], v28 offset:8
    ds_read_b64_tr_b16 v[50:51], v28 offset:72
    ds_read_b64_tr_b16 v[36:37], v28 offset:512
    ds_read_b64_tr_b16 v[38:39], v28 offset:576
    ds_read_b64_tr_b16 v[52:53], v28 offset:520
    ds_read_b64_tr_b16 v[54:55], v28 offset:584
    ds_read_b64_tr_b16 v[40:41], v28 offset:1056
    ds_read_b64_tr_b16 v[42:43], v28 offset:1120
    ds_read_b64_tr_b16 v[56:57], v28 offset:1064
    ds_read_b64_tr_b16 v[58:59], v28 offset:1128
    ds_read_b64_tr_b16 v[44:45], v28 offset:1568
    ds_read_b64_tr_b16 v[46:47], v28 offset:1632
    ds_read_b64_tr_b16 v[60:61], v28 offset:1576
    ds_read_b64_tr_b16 v[62:63], v28 offset:1640
    v_lshrrev_b32 v29, 2, v2
    s_movk_i32 s55, 4400
    v_mul_u32_u24 v18, s55, v29
    s_movk_i32 s55, 272
    v_mad_u32_u24 v18, v7, s55, v18
    v_lshl_add_u32 v18, v3, 4, v18
    s_sub_u32 s54, s3, 12
    s_lshl_b32 s54, s54, 6
    s_mul_i32 s55, s2, 10240
    s_add_u32 s54, s54, s55
    v_lshl_add_u32 v122, v29, 4, v7
    v_lshlrev_b32 v122, 8, v122
    v_lshl_add_u32 v122, v3, 4, v122
    v_add_u32 v122, s54, v122
    v_cmp_gt_u32 vcc, 8, v2
    v_mov_b32 v29, 2048
    v_cndmask_b32 v29, 0, v29, vcc
    v_add_u32 v123, v122, v29
    v_mov_b32 v28, 0
L_fsa:
    ds_read_b32 v29, v28 offset:26708
    s_waitcnt lgkmcnt(0)
    v_readfirstlane_b32 s54, v29
    s_and_b32 s54, s54, 0xff0000ff
    s_cmp_lg_u32 s54, 0x4000004
    s_cbranch_scc1 L_fsa
    ds_read_b128 v[64:67], v18 offset:12288
    ds_read_b128 v[68:71], v18 offset:12352
    ds_read_b128 v[72:75], v18 offset:12416
    ds_read_b128 v[76:79], v18 offset:12480
    ds_read_b128 v[80:83], v18 offset:15552
    ds_read_b128 v[84:87], v18 offset:15616
    ds_read_b128 v[88:91], v18 offset:15680
    ds_read_b128 v[92:95], v18 offset:15744
    s_waitcnt lgkmcnt(7)
    v_mfma_f32_16x16x32_bf16 v[112:115], v[32:35], v[64:67], 0
    v_mfma_f32_16x16x32_bf16 v[116:119], v[48:51], v[64:67], 0
    s_waitcnt lgkmcnt(6)
    v_mfma_f32_16x16x32_bf16 v[112:115], v[36:39], v[68:71], v[112:115]
    v_mfma_f32_16x16x32_bf16 v[116:119], v[52:55], v[68:71], v[116:119]
    s_waitcnt lgkmcnt(5)
    v_mfma_f32_16x16x32_bf16 v[112:115], v[40:43], v[72:75], v[112:115]
    v_mfma_f32_16x16x32_bf16 v[116:119], v[56:59], v[72:75], v[116:119]
    s_waitcnt lgkmcnt(4)
    v_mfma_f32_16x16x32_bf16 v[112:115], v[44:47], v[76:79], v[112:115]
    v_mfma_f32_16x16x32_bf16 v[116:119], v[60:63], v[76:79], v[116:119]
    s_waitcnt lgkmcnt(3)
    v_mfma_f32_16x16x32_bf16 v[20:23], v[32:35], v[80:83], 0
    v_mfma_f32_16x16x32_bf16 v[24:27], v[48:51], v[80:83], 0
    s_waitcnt lgkmcnt(2)
    v_mfma_f32_16x16x32_bf16 v[20:23], v[36:39], v[84:87], v[20:23]
    v_mfma_f32_16x16x32_bf16 v[24:27], v[52:55], v[84:87], v[24:27]
    s_waitcnt lgkmcnt(1)
    v_mfma_f32_16x16x32_bf16 v[20:23], v[40:43], v[88:91], v[20:23]
    v_mfma_f32_16x16x32_bf16 v[24:27], v[56:59], v[88:91], v[24:27]
    s_waitcnt lgkmcnt(0)
    v_mfma_f32_16x16x32_bf16 v[20:23], v[44:47], v[92:95], v[20:23]
    v_mfma_f32_16x16x32_bf16 v[24:27], v[60:63], v[92:95], v[24:27]
L_fsc:
    ds_read_b32 v29, v28 offset:26708
    s_waitcnt lgkmcnt(0)
    v_readfirstlane_b32 s54, v29
    s_and_b32 s54, s54, 0xff00
    s_cmp_lg_u32 s54, 0x400
    s_cbranch_scc1 L_fsc
    ds_read_b128 v[96:99], v18 offset:13376
    ds_read_b128 v[100:103], v18 offset:13440
    ds_read_b128 v[104:107], v18 offset:13504
    ds_read_b128 v[108:111], v18 offset:13568
    s_nop 1
    v_cvt_pk_bf16_f32 v8, v112, v113
    v_cvt_pk_bf16_f32 v9, v114, v115
    v_cvt_pk_bf16_f32 v10, v116, v117
    v_cvt_pk_bf16_f32 v11, v118, v119
    s_mov_b32 exec_lo, 0x00ff00ff
    s_mov_b32 exec_hi, 0x00ff00ff
    buffer_store_dwordx4 v[8:11], v122, s[32:35], 0 offen offset:0
    v_mov_b32 v112, 0
    v_mov_b32 v113, 0
    v_mov_b32 v114, 0
    v_mov_b32 v115, 0
    v_mov_b32 v116, 0
    v_mov_b32 v117, 0
    v_mov_b32 v118, 0
    v_mov_b32 v119, 0
    s_mov_b64 exec, -1
    v_cvt_pk_bf16_f32 v12, v20, v21
    v_cvt_pk_bf16_f32 v13, v22, v23
    v_cvt_pk_bf16_f32 v14, v24, v25
    v_cvt_pk_bf16_f32 v15, v26, v27
    s_mov_b32 exec_lo, 0x00ff00ff
    s_mov_b32 exec_hi, 0x00ff00ff
    buffer_store_dwordx4 v[12:15], v122, s[32:35], 0 offen offset:3072
    v_mov_b32 v20, 0
    v_mov_b32 v21, 0
    v_mov_b32 v22, 0
    v_mov_b32 v23, 0
    v_mov_b32 v24, 0
    v_mov_b32 v25, 0
    v_mov_b32 v26, 0
    v_mov_b32 v27, 0
    s_mov_b64 exec, -1
    s_nop 1
    s_waitcnt lgkmcnt(3)
    v_mfma_f32_16x16x32_bf16 v[20:23], v[32:35], v[96:99], v[20:23]
    v_mfma_f32_16x16x32_bf16 v[24:27], v[48:51], v[96:99], v[24:27]
    s_waitcnt lgkmcnt(2)
    v_mfma_f32_16x16x32_bf16 v[20:23], v[36:39], v[100:103], v[20:23]
    v_mfma_f32_16x16x32_bf16 v[24:27], v[52:55], v[100:103], v[24:27]
    s_waitcnt lgkmcnt(1)
    v_mfma_f32_16x16x32_bf16 v[20:23], v[40:43], v[104:107], v[20:23]
    v_mfma_f32_16x16x32_bf16 v[24:27], v[56:59], v[104:107], v[24:27]
    s_waitcnt lgkmcnt(0)
    v_mfma_f32_16x16x32_bf16 v[20:23], v[44:47], v[108:111], v[20:23]
    v_mfma_f32_16x16x32_bf16 v[24:27], v[60:63], v[108:111], v[24:27]
L_fsd:
    ds_read_b32 v29, v28 offset:26708
    s_waitcnt lgkmcnt(0)
    v_readfirstlane_b32 s54, v29
    s_and_b32 s54, s54, 0xff0000
    s_cmp_lg_u32 s54, 0x40000
    s_cbranch_scc1 L_fsd
    ds_read_b128 v[64:67], v18 offset:14464
    ds_read_b128 v[68:71], v18 offset:14528
    ds_read_b128 v[72:75], v18 offset:14592
    ds_read_b128 v[76:79], v18 offset:14656
    v_cvt_pk_bf16_f32 v8, v20, v21
    v_cvt_pk_bf16_f32 v9, v22, v23
    v_cvt_pk_bf16_f32 v10, v24, v25
    v_cvt_pk_bf16_f32 v11, v26, v27
    s_mov_b32 exec_lo, 0x0fff0fff
    s_mov_b32 exec_hi, 0x0fff0fff
    buffer_store_dwordx4 v[8:11], v122, s[32:35], 0 offen offset:1024
    s_mov_b64 exec, -1
    s_waitcnt lgkmcnt(3)
    v_mfma_f32_16x16x32_bf16 v[112:115], v[32:35], v[64:67], v[112:115]
    v_mfma_f32_16x16x32_bf16 v[116:119], v[48:51], v[64:67], v[116:119]
    s_waitcnt lgkmcnt(2)
    v_mfma_f32_16x16x32_bf16 v[112:115], v[36:39], v[68:71], v[112:115]
    v_mfma_f32_16x16x32_bf16 v[116:119], v[52:55], v[68:71], v[116:119]
    s_waitcnt lgkmcnt(1)
    v_mfma_f32_16x16x32_bf16 v[112:115], v[40:43], v[72:75], v[112:115]
    v_mfma_f32_16x16x32_bf16 v[116:119], v[56:59], v[72:75], v[116:119]
    s_waitcnt lgkmcnt(0)
    v_mfma_f32_16x16x32_bf16 v[112:115], v[44:47], v[76:79], v[112:115]
    v_mfma_f32_16x16x32_bf16 v[116:119], v[60:63], v[76:79], v[116:119]
    s_nop 7
    v_cvt_pk_bf16_f32 v12, v112, v113
    v_cvt_pk_bf16_f32 v13, v114, v115
    v_cvt_pk_bf16_f32 v14, v116, v117
    v_cvt_pk_bf16_f32 v15, v118, v119
    s_mov_b32 exec_lo, 0x0fff0fff
    s_mov_b32 exec_hi, 0x0fff0fff
    buffer_store_dwordx4 v[12:15], v123, s[32:35], 0 offen offset:0
    s_mov_b64 exec, -1
    s_branch L_fin
L_b3:
    s_waitcnt lgkmcnt(0)
L_fin:
L_end:
    s_endpgm
L_chk:
    v_lshrrev_b32 v28, 6, v0
    v_and_b32 v1, 63, v0
    v_readfirstlane_b32 s3, v28
    s_cmp_lg_u32 s3, 0
    s_cbranch_scc1 L_chk_end
    v_mov_b32 v28, 0
    v_lshlrev_b32 v29, 7, v1
    s_waitcnt lgkmcnt(0)
    global_load_dword v126, v28, s[22:23]
    s_add_u32 s42, s22, 262144000
    s_addc_u32 s43, s23, 0
    v_add_u32 v32, 4227072, v29
    v_add_u32 v33, 4235264, v29
    v_add_u32 v34, 4243456, v29
    v_add_u32 v35, 4251648, v29
    s_mov_b32 s50, 0
    s_waitcnt vmcnt(0)
    v_readfirstlane_b32 s40, v126
    s_xor_b32 s37, s40, 0x3c6ef372
L_chk_poll:
    global_load_dword v36, v32, s[42:43] sc1
    global_load_dword v37, v33, s[42:43] sc1
    global_load_dword v38, v34, s[42:43] sc1
    global_load_dword v39, v35, s[42:43] sc1
    s_add_u32 s50, s50, 1
    s_cmp_gt_u32 s50, 1048576
    s_cbranch_scc1 L_chk_adv
    s_waitcnt vmcnt(0)
    v_cmp_ne_u32 s[64:65], s37, v36
    v_cmp_ne_u32 s[66:67], s37, v37
    v_cmp_ne_u32 s[68:69], s37, v38
    v_cmp_ne_u32 s[70:71], s37, v39
    s_and_b32 s71, s71, 0x3ffffff
    s_or_b64 s[64:65], s[64:65], s[66:67]
    s_or_b64 s[64:65], s[64:65], s[68:69]
    s_or_b64 s[64:65], s[64:65], s[70:71]
    s_cmp_lg_u64 s[64:65], 0
    s_cbranch_scc1 L_chk_poll
L_chk_adv:
    s_waitcnt vmcnt(0)
    s_add_u32 s54, s40, 1
    v_mov_b32 v29, s54
    s_mov_b64 exec, 1
    global_store_dword v28, v29, s[22:23]
L_chk_end:
    s_endpgm
L_slow:
    v_mov_b32 v28, 0
L_syqs:
    ds_read_b32 v29, v28 offset:26700
    s_waitcnt lgkmcnt(0)
    v_readfirstlane_b32 s54, v29
    s_and_b32 s54, s54, 16711680
    s_cmp_lg_u32 s54, 262144
    s_cbranch_scc1 L_syqs
    s_mul_i32 s54, s3, 272
    s_movk_i32 s55, 4400
    v_mul_u32_u24 v28, s55, v7
    v_lshl_add_u32 v28, v3, 4, v28
    v_add_u32 v28, s54, v28
    s_mov_b32 exec_lo, 0x0f0f0f0f
    s_mov_b32 exec_hi, 0x0f0f0f0f
    ds_read_b128 v[96:99], v28 offset:12288
    ds_read_b128 v[100:103], v28 offset:12352
    ds_read_b128 v[104:107], v28 offset:12416
    ds_read_b128 v[108:111], v28 offset:12480
    s_mov_b32 exec_lo, 0xf0f0f0f0
    s_mov_b32 exec_hi, 0xf0f0f0f0
    ds_read_b128 v[80:83], v28 offset:12288
    ds_read_b128 v[84:87], v28 offset:12352
    ds_read_b128 v[88:91], v28 offset:12416
    ds_read_b128 v[92:95], v28 offset:12480
    s_mov_b64 exec, -1
    s_mov_b32 s39, 1
L_fill:
    s_waitcnt vmcnt(0) lgkmcnt(0)
    s_mov_b32 s50, 0
    s_mul_i32 s57, s3, 768
L_fill_loop:
    s_cmp_ge_u32 s52, 320000
    s_cbranch_scc1 L_fill_done
    s_cmp_gt_u32 s50, 128
    s_cbranch_scc1 L_fill_done
    v_add_u32 v28, s52, v1
    v_lshlrev_b32 v28, 2, v28
    global_load_dword v122, v28, s[12:13]
    global_load_dword v123, v28, s[10:11]
    s_movk_i32 s54, -40
    s_waitcnt vmcnt(0)
    v_mul_u32_u24 v28, 52429, v122
    v_lshrrev_b32 v28, 21, v28
    v_cmp_eq_u32 vcc, s2, v28
    v_mad_i32_i24 v28, v28, s54, v122
    v_lshrrev_b32 v29, 5, v28
    v_and_b32 v29, v29, v1
    v_lshl_add_u32 v28, v29, 3, v28
    v_and_b32 v29, 15, v28
    v_cmp_eq_u32 s[58:59], s3, v29
    v_lshrrev_b32 v30, 4, v28
    s_movk_i32 s54, 0xfb
    v_lshrrev_b32_e64 v30, v30, s54
    s_and_b64 vcc, vcc, s[58:59]
    v_lshl_or_b32 v29, v123, 8, v30
    v_mbcnt_lo_u32_b32 v30, vcc_lo, 0
    v_mbcnt_hi_u32_b32 v30, vcc_hi, v30
    v_add_u32 v30, s50, v30
    v_lshlrev_b32 v30, 2, v30
    v_add_u32 v30, s57, v30
    s_bcnt1_i32_b64 s55, vcc
    s_and_saveexec_b64 s[58:59], vcc
    s_cbranch_execz L_fill_skip
    ds_write_b32 v30, v29 offset:0
L_fill_skip:
    s_mov_b64 exec, s[58:59]
    s_add_u32 s50, s50, s55
    s_add_u32 s52, s52, 64
    s_branch L_fill_loop
L_fill_done:
    s_add_u32 s54, s50, 31
    s_and_b32 s54, s54, 0xffffffe0
    v_add_u32 v28, s50, v1
    v_cmp_gt_u32 vcc, s54, v28
    v_lshlrev_b32 v28, 2, v28
    v_add_u32 v28, s57, v28
    v_mov_b32 v29, 0x3fffff
    s_and_saveexec_b64 s[58:59], vcc
    s_cbranch_execz L_pad_skip
    ds_write_b32 v28, v29 offset:0
L_pad_skip:
    s_mov_b64 exec, s[58:59]
    s_waitcnt lgkmcnt(0)
    ds_read_b32 v19, v5 offset:0
    s_branch L_main
.section .rodata,"a"
.p2align 6
.amdhsa_kernel gather_scatter__kernel_systems_refs_featgraph__graph_kernel
  .amdhsa_next_free_vgpr 128
  .amdhsa_next_free_sgpr 102
  .amdhsa_accum_offset 128
  .amdhsa_group_segment_fixed_size 0
  .amdhsa_kernarg_size 64
  .amdhsa_user_sgpr_count 2
  .amdhsa_user_sgpr_kernarg_segment_ptr 1
  .amdhsa_system_sgpr_workgroup_id_x 1
.end_amdhsa_kernel
```
